```python
import torch

def _softmax(x, axis=-1):
    return torch.softmax(x, dim=axis)
def _gelu(x):
    return torch.nn.functional.gelu(x, approximate="tanh")
def _silu(x):
    return torch.nn.functional.silu(x)
def _sigmoid(x):
    return torch.sigmoid(x)
def _layernorm(x, axis=-1, eps=1e-5):
    m = x.mean(dim=axis, keepdim=True)
    v = x.var(dim=axis, keepdim=True, unbiased=False)
    return (x - m) / torch.sqrt(v + eps)
def _scatter_add(tgt, idx, src, axis=0):
    return tgt.clone().index_add_(axis, idx, src)
def _segment_sum(src, seg, n):
    out = torch.zeros((n,) + src.shape[1:], dtype=src.dtype)
    return out.index_add_(0, seg, src)
def _pad(x, pw):
    flat = tuple(v for pair in reversed(pw) for v in pair)
    return torch.nn.functional.pad(x, flat)

kernel_name = 'standalone__mpnn_edge_mlp__graph'

def setup_inputs():

    _w = (lambda a: (lambda t: t.to(torch.bfloat16) if t.is_floating_point() else t)(torch.as_tensor(a)))
    N, deg, D, De = 12500, 64, 64, max(16, 1)
    E = N * deg
    return {
        "x": _w((lambda *s: torch.randn(*s, dtype=torch.bfloat16) * 0.05)(N, D)),
        "e_attr": _w((lambda *s: torch.randn(*s, dtype=torch.bfloat16) * 0.4)(E, De)),
        "src": _w((lambda lo, hi, *s: torch.randint(lo, hi, s))(0, N, E).to(torch.int64)),
        "dst": _w((lambda lo, hi, *s: torch.randint(lo, hi, s))(0, N, E).to(torch.int64)),
        "w_msg": _w((lambda *s: torch.randn(*s, dtype=torch.bfloat16) * 0.4)(2 * D + De, D)),
        "w_upd": _w((lambda *s: torch.randn(*s, dtype=torch.bfloat16) * 0.05)(2 * D, D)),
    }

def reference(x, e_attr, src, dst, w_msg, w_upd):
    N, D = x.shape
    m_in = torch.concatenate([x[src], x[dst], e_attr], axis=-1)
    msg = _silu(m_in @ w_msg)
    agg = _segment_sum(msg, dst, N)
    return _silu(torch.concatenate([x, agg], axis=-1) @ w_upd)
```

```asm
; @launch grid=(256,1,1) block=(768,1,1) lds=163328
.amdgcn_target "amdgcn-amd-amdhsa--gfx950"
.text
.globl standalone__mpnn_edge_mlp__graph_kernel
.p2align 8
.type standalone__mpnn_edge_mlp__graph_kernel,@function
standalone__mpnn_edge_mlp__graph_kernel:
    s_cmp_ge_u32 s2, 256
    s_cbranch_scc1 K_END
    s_load_dwordx16 s[44:59], s[0:1], 0
    s_load_dwordx2 s[10:11], s[0:1], 64
    s_memrealtime s[98:99]
    s_cmp_ge_u32 s2, 32
    s_cbranch_scc1 K_NOCPF2
    s_getpc_b64 s[8:9]
K_PC:
    v_cmp_gt_u32 vcc, (K_CODE_END-K_PC)/128, v0
    v_lshlrev_b32 v120, 7, v0
    s_and_saveexec_b64 s[36:37], vcc
    s_cbranch_execz K_NOCPF
    global_load_dword v121, v120, s[8:9]
K_NOCPF:
    s_mov_b64 exec, s[36:37]
K_NOCPF2:
    s_and_b32 s40, s2, 7
    s_lshl_b32 s12, s40, 5
    s_lshr_b32 s41, s2, 3
    s_or_b32 s12, s12, s41
    v_lshrrev_b32 v64, 6, v0
    v_and_b32 v1, 63, v0
    v_readfirstlane_b32 s13, v64
    v_lshlrev_b32 v116, 4, v0
    v_lshlrev_b32 v117, 2, v0
    v_mov_b32 v64, 0
    v_mov_b32 v65, 0
    v_mov_b32 v66, 0
    v_mov_b32 v67, 0
    s_mul_i32 s35, s2, 12800
    s_add_u32 s43, s35, 12288
    s_cmp_ge_u32 s13, 4
    s_cbranch_scc1 K_NOHZ
    ds_write_b32 v117, v64 offset:6144
K_NOHZ:
    s_waitcnt lgkmcnt(0)
    s_mov_b32 s60, s50
    s_and_b32 s61, s51, 0xffff
    s_mov_b32 s62, 3200000
    s_mov_b32 s63, 0x20000
    buffer_load_dwordx4 v[88:91], v116, s[60:63], s35 offen nt
    s_cmp_ge_u32 s13, 2
    s_cbranch_scc1 K_NOD5
    buffer_load_dword v92, v117, s[60:63], s43 offen nt
K_NOD5:
    s_mov_b32 s100, s43
    s_mov_b32 s40, s58
    s_and_b32 s41, s59, 0xffff
    s_mov_b32 s42, 256
    s_mov_b32 s43, 0x20000
    s_or_b32 s3, s2, s13
    s_cmp_lg_u32 s3, 0
    s_cbranch_scc1 K_NONON
    s_and_b32 s99, s99, 0xff
    s_or_b32 s99, s99, 0x100
    v_mov_b32 v68, s98
    v_mov_b32 v69, s99
    s_mov_b64 exec, 1
    buffer_store_dwordx2 v[68:69], v64, s[40:43], 0 offen sc1
    s_mov_b64 exec, -1
K_NONON:
    s_barrier
    s_mov_b32 s64, s48
    s_and_b32 s65, s49, 0xffff
    s_mov_b32 s66, 3200000
    s_mov_b32 s67, 0x20000
    s_mov_b32 s36, s52
    s_and_b32 s37, s53, 0xffff
    s_mov_b32 s38, 18432
    s_mov_b32 s39, 0x20000
    s_mov_b32 s4, s54
    s_and_b32 s5, s55, 0xffff
    s_mov_b32 s6, 16384
    s_mov_b32 s7, 0x20000
    s_mov_b32 s16, s44
    s_and_b32 s17, s45, 0xffff
    s_mov_b32 s18, 1600000
    s_mov_b32 s19, 0x20000
    s_mov_b32 s20, s46
    s_and_b32 s21, s47, 0xffff
    s_mov_b32 s22, 25600000
    s_mov_b32 s23, 0x20000
    s_mov_b32 s24, s10
    s_and_b32 s25, s11, 0xffff
    s_mov_b32 s26, 3728384
    s_mov_b32 s27, 0x20000
    s_mov_b32 s28, s56
    s_and_b32 s29, s57, 0xffff
    s_mov_b32 s30, 1600000
    s_mov_b32 s31, 0x20000
    v_lshrrev_b32 v163, 4, v1
    s_mul_i32 s101, s12, 6272
    v_and_b32 v78, 1, v163
    v_lshlrev_b32 v78, 2, v78
    v_xor_b32 v78, v78, v1
    v_lshlrev_b32 v118, 4, v78
    v_xor_b32 v78, v163, v1
    v_and_b32 v78, 7, v78
    v_lshlrev_b32 v78, 4, v78
    v_lshrrev_b32 v79, 3, v1
    v_lshl_add_u32 v119, v79, 7, v78
    v_xor_b32 v115, 64, v119
    s_cmp_ge_u32 s13, 9
    s_cbranch_scc1 K_DAXO
    s_lshl_b32 s3, s13, 11
    s_add_u32 m0, s3, 78336
    s_nop 0
    buffer_load_dwordx4 v118, s[36:39], s3 offen lds
    buffer_load_dwordx4 v118, s[36:39], s3 offen offset:1024 lds
    s_branch K_DAD
K_DAXO:
    s_sub_u32 s9, s13, 9
    s_lshl_b32 s3, s9, 11
    s_add_u32 m0, s3, 139776
    s_add_u32 s9, s3, s101
    buffer_load_dwordx4 v119, s[16:19], s9 offen lds
    buffer_load_dwordx4 v115, s[16:19], s9 offen offset:1024 lds
    s_cmp_lg_u32 s13, 9
    s_cbranch_scc1 K_DAD
    s_mov_b32 m0, 145920
    s_add_u32 s3, s101, 6144
    buffer_load_dwordx4 v119, s[16:19], s3 offen lds
K_DAD:
    s_mov_b32 s15, 0
    v_mul_u32_u24 v72, 43, v1
    v_lshrrev_b32 v72, 7, v72
    v_mul_u32_u24 v73, 3, v72
    v_sub_u32 v73, v1, v73
    v_lshlrev_b32 v161, 2, v73
    s_mul_i32 s3, s13, 21
    v_add_u32 v160, s3, v72
    v_cmp_gt_u32 vcc, 63, v1
    v_mov_b32 v73, 255
    s_lshl_b32 s14, s12, 3
    v_cndmask_b32 v160, v73, v160, vcc
    s_lshr_b32 s33, s13, 2
    s_and_b32 s34, s13, 3
    v_and_b32 v162, 15, v1
    v_lshrrev_b32 v163, 4, v1
    s_lshl_b32 s68, s33, 11
    s_add_u32 s68, s68, s101
    s_add_u32 s69, s101, 6144
    v_lshrrev_b32 v164, 1, v162
    v_xor_b32 v164, v164, v163
    v_lshlrev_b32 v164, 4, v164
    v_lshl_add_u32 v164, v162, 7, v164
    v_add_u32 v164, 139776, v164
    v_lshrrev_b32 v68, 5, v0
    v_mul_u32_u24 v68, 768, v68
    v_and_b32 v69, 31, v0
    v_lshl_add_u32 v68, v69, 4, v68
    v_add_u32 v68, 38400, v68
    ds_write_b128 v68, v[64:67]
    ds_write_b128 v68, v[64:67] offset:18432
    s_cmp_ge_u32 s13, 2
    s_cbranch_scc1 K_Z3
    ds_write_b128 v68, v[64:67] offset:36864
K_Z3:
    s_mul_i32 s32, s13, 5120
    s_add_u32 s32, s32, 78336
    s_mov_b32 s70, 0xbfb8aa3b
    s_mov_b32 s71, 0xbfb8aa3b
    s_mov_b32 s96, 0x30800000
    s_mov_b32 s97, 0x30800000
    v_and_b32 v70, 31, v1
    v_lshrrev_b32 v71, 5, v1
    v_lshlrev_b32 v6, 3, v70
    v_add_u32 v6, 38400, v6
    v_bfe_u32 v72, v70, 2, 1
    v_lshrrev_b32 v73, 3, v70
    v_lshl_or_b32 v73, v72, 2, v73
    v_and_b32 v74, 3, v70
    v_lshl_or_b32 v75, v73, 2, v74
    v_cmp_eq_u32 vcc, v72, v71
    v_mov_b32 v34, 0
    v_mov_b32 v35, 0
    v_mov_b32 v32, 0x3f803f80
    v_cndmask_b32 v32, 0, v32, vcc
    v_cmp_gt_u32 vcc, 16, v70
    v_lshl_or_b32 v76, v72, 2, v74
    v_xor_b32 v76, v76, v71
    v_cndmask_b32 v33, v32, 0, vcc
    v_cndmask_b32 v32, 0, v32, vcc
    v_lshlrev_b32 v77, 10, v74
    v_lshl_add_u32 v77, v73, 7, v77
    v_add_u32 v77, s32, v77
    v_xor_b32 v78, 0, v76
    v_lshl_add_u32 v9, v78, 4, v77
    v_xor_b32 v78, 2, v76
    v_lshl_add_u32 v10, v78, 4, v77
    v_xor_b32 v78, 4, v76
    v_lshl_add_u32 v11, v78, 4, v77
    v_xor_b32 v78, 6, v76
    v_lshl_add_u32 v12, v78, 4, v77
    v_bfe_u32 v78, v75, 3, 1
    v_xor_b32 v78, v78, v71
    v_lshlrev_b32 v78, 4, v78
    v_lshl_add_u32 v78, v75, 5, v78
    s_add_u32 s3, s32, 4096
    v_add_u32 v13, s3, v78
    v_lshlrev_b32 v78, 2, v71
    v_and_b32 v79, 7, v1
    v_xor_b32 v78, v78, v79
    v_lshlrev_b32 v7, 4, v78
    v_xor_b32 v78, v163, v1
    v_and_b32 v78, 1, v78
    v_lshlrev_b32 v8, 4, v78
    v_bfe_u32 v78, v1, 3, 1
    v_lshlrev_b32 v78, 4, v78
    v_add_u32 v4, 9216, v78
    v_bfe_u32 v78, v1, 1, 3
    v_lshlrev_b32 v78, 2, v78
    v_add_u32 v5, 23808, v78
    v_mov_b32 v78, 1
    s_cmp_eq_u32 s13, 9
    s_cbranch_scc1 K_DW1
    s_waitcnt vmcnt(2)
K_DW1:
    s_waitcnt vmcnt(3)
    s_cmp_ge_u32 s13, 2
    s_cbranch_scc1 K_NOS5
    buffer_load_dword v100, v117, s[64:67], s100 offen nt
K_NOS5:
    buffer_load_dwordx4 v[96:99], v116, s[64:67], s35 offen nt
    s_cmp_lg_u32 s13, 11
    s_cbranch_scc1 K_NN0
    buffer_load_dwordx2 v[68:69], v64, s[40:43], 0 offen
K_NN0:
    s_cmp_ge_u32 s2, 250
    s_cbranch_scc1 K_PDONE
    s_mov_b32 s8, -49
    v_mul_u32_u24 v104, 21400, v88
    v_lshrrev_b32 v70, 20, v104
    v_lshlrev_b32 v104, 2, v70
    ds_add_rtn_u32 v110, v104, v78 offset:6144
    v_mul_u32_u24 v105, 21400, v89
    v_lshrrev_b32 v71, 20, v105
    v_lshlrev_b32 v105, 2, v71
    ds_add_rtn_u32 v111, v105, v78 offset:6144
    v_mul_u32_u24 v106, 21400, v90
    v_lshrrev_b32 v72, 20, v106
    v_lshlrev_b32 v106, 2, v72
    ds_add_rtn_u32 v112, v106, v78 offset:6144
    v_mul_u32_u24 v107, 21400, v91
    v_lshrrev_b32 v73, 20, v107
    v_lshlrev_b32 v107, 2, v73
    ds_add_rtn_u32 v113, v107, v78 offset:6144
    s_cmp_ge_u32 s13, 2
    s_cbranch_scc1 K_F0
    v_mul_u32_u24 v108, 21400, v92
    v_lshrrev_b32 v74, 20, v108
    v_lshlrev_b32 v108, 2, v74
    ds_add_rtn_u32 v114, v108, v78 offset:6144
K_F0:
    v_mad_i32_i24 v88, v70, s8, v88
    v_add_u32 v77, 0, v117
    v_lshl_or_b32 v88, v88, 12, v77
    v_mad_i32_i24 v89, v71, s8, v89
    v_add_u32 v77, 1, v117
    v_lshl_or_b32 v89, v89, 12, v77
    v_mad_i32_i24 v90, v72, s8, v90
    v_add_u32 v77, 2, v117
    v_lshl_or_b32 v90, v90, 12, v77
    v_mad_i32_i24 v91, v73, s8, v91
    v_add_u32 v77, 3, v117
    v_lshl_or_b32 v91, v91, 12, v77
    v_mad_i32_i24 v92, v74, s8, v92
    v_add_u32 v77, 3072, v0
    v_lshl_or_b32 v92, v92, 12, v77
    s_waitcnt lgkmcnt(0)
    s_barrier
    s_cmp_lg_u32 s13, 0
    s_cbranch_scc1 K_NOSCAN
    ds_read_b128 v[36:39], v116 offset:6144
    s_waitcnt lgkmcnt(0)
    v_add_u32 v40, v36, v37
    v_add_u32 v41, v40, v38
    v_add_u32 v42, v41, v39
    v_mov_b32 v43, v42
    s_nop 1
    v_add_u32_dpp v43, v43, v43 row_shr:1 row_mask:0xf bank_mask:0xf bound_ctrl:0
    s_nop 1
    v_add_u32_dpp v43, v43, v43 row_shr:2 row_mask:0xf bank_mask:0xf bound_ctrl:0
    s_nop 1
    v_add_u32_dpp v43, v43, v43 row_shr:4 row_mask:0xf bank_mask:0xf bound_ctrl:0
    s_nop 1
    v_add_u32_dpp v43, v43, v43 row_shr:8 row_mask:0xf bank_mask:0xf bound_ctrl:0
    s_nop 1
    v_add_u32_dpp v43, v43, v43 row_bcast:15 row_mask:0xa bank_mask:0xf
    s_nop 1
    v_add_u32_dpp v43, v43, v43 row_bcast:31 row_mask:0xc bank_mask:0xf
    v_sub_u32 v44, v43, v42
    v_add_u32 v45, v44, v36
    v_add_u32 v46, v44, v40
    v_add_u32 v47, v44, v41
    ds_write_b128 v116, v[44:47] offset:6144
    v_lshl_or_b32 v48, v36, 12, v44
    v_lshl_or_b32 v50, v37, 12, v45
    v_lshl_or_b32 v52, v38, 12, v46
    v_lshl_or_b32 v54, v39, 12, v47
K_NOSCAN:
    s_waitcnt lgkmcnt(0)
    s_barrier
    ds_read_b32 v104, v104 offset:6144
    ds_read_b32 v105, v105 offset:6144
    ds_read_b32 v106, v106 offset:6144
    ds_read_b32 v107, v107 offset:6144
    s_cmp_ge_u32 s13, 2
    s_cbranch_scc1 K_F1
    ds_read_b32 v108, v108 offset:6144
K_F1:
    s_waitcnt vmcnt(0)
    v_lshl_or_b32 v88, v96, 18, v88
    v_lshl_or_b32 v89, v97, 18, v89
    v_lshl_or_b32 v90, v98, 18, v90
    v_lshl_or_b32 v91, v99, 18, v91
    v_lshl_or_b32 v92, v100, 18, v92
    s_waitcnt lgkmcnt(0)
    v_add_lshl_u32 v104, v104, v110, 2
    ds_write_b32 v104, v88 offset:9216
    v_add_lshl_u32 v105, v105, v111, 2
    ds_write_b32 v105, v89 offset:9216
    v_add_lshl_u32 v106, v106, v112, 2
    ds_write_b32 v106, v90 offset:9216
    v_add_lshl_u32 v107, v107, v113, 2
    ds_write_b32 v107, v91 offset:9216
    s_cmp_ge_u32 s13, 2
    s_cbranch_scc1 K_F2
    v_add_lshl_u32 v108, v108, v114, 2
    ds_write_b32 v108, v92 offset:9216
K_F2:
    s_cmp_lg_u32 s13, 11
    s_cbranch_scc1 K_NAX
    s_mov_b32 s9, 200000
K_NAL:
    v_readfirstlane_b32 s3, v69
    s_cmp_lg_u32 s3, 0
    s_cbranch_scc1 K_NAD
    s_sub_u32 s9, s9, 1
    s_cmp_eq_u32 s9, 0
    s_cbranch_scc1 K_NAD
    buffer_load_dwordx2 v[68:69], v64, s[40:43], 0 offen sc1
    s_waitcnt vmcnt(0)
    s_branch K_NAL
K_NAD:
    ds_write_b64 v64, v[68:69] offset:7168
K_NAX:
    s_add_u32 s35, s35, 524288
    s_waitcnt lgkmcnt(0)
    s_barrier
    ds_read_b128 v[88:91], v116 offset:9216
    ds_read_b64 v[68:69], v64 offset:7168
    s_cmp_lg_u32 s13, 1
    s_cbranch_scc1 K_NOX1
    v_lshlrev_b32 v104, 4, v1
    s_mov_b32 exec_hi, 0
    ds_read_b128 v[96:99], v104 offset:21504
    s_add_u32 s3, s35, 12288
    s_waitcnt lgkmcnt(0)
    buffer_store_dwordx4 v[96:99], v104, s[24:27], s3 offen sc1
    s_mov_b64 exec, -1
K_NOX1:
    s_waitcnt lgkmcnt(0)
    buffer_store_dwordx4 v[88:91], v116, s[24:27], s35 offen sc1
    v_readfirstlane_b32 s99, v68
    v_readfirstlane_b32 s98, v69
    s_lshl_b32 s98, s98, 24
    s_nop 0
    v_or_b32 v48, s98, v48
    v_mov_b32 v49, s99
    v_or_b32 v50, s98, v50
    v_mov_b32 v51, s99
    v_or_b32 v52, s98, v52
    v_mov_b32 v53, s99
    v_or_b32 v54, s98, v54
    v_mov_b32 v55, s99
    v_lshlrev_b32 v70, 5, v1
    s_lshl_b32 s3, s2, 11
    s_waitcnt vmcnt(0)
    s_barrier
    s_cmp_lg_u32 s13, 0
    s_cbranch_scc1 K_NOPUB
    buffer_store_dwordx4 v[48:51], v70, s[24:27], s3 offen sc1
    buffer_store_dwordx4 v[52:55], v70, s[24:27], s3 offen offset:16 sc1
    s_branch K_NOPUB
K_PDONE:
    s_waitcnt vmcnt(0)
    s_cmp_lg_u32 s13, 11
    s_cbranch_scc1 K_NBX
    s_mov_b32 s9, 200000
K_NBL:
    v_readfirstlane_b32 s3, v69
    s_cmp_lg_u32 s3, 0
    s_cbranch_scc1 K_NBD
    s_sub_u32 s9, s9, 1
    s_cmp_eq_u32 s9, 0
    s_cbranch_scc1 K_NBD
    buffer_load_dwordx2 v[68:69], v64, s[40:43], 0 offen sc1
    s_waitcnt vmcnt(0)
    s_branch K_NBL
K_NBD:
    ds_write_b64 v64, v[68:69] offset:7168
K_NBX:
    s_waitcnt lgkmcnt(0)
    s_barrier
    ds_read_b64 v[68:69], v64 offset:7168
    s_waitcnt lgkmcnt(0)
    v_readfirstlane_b32 s99, v68
    v_readfirstlane_b32 s98, v69
    s_lshl_b32 s98, s98, 24
K_NOPUB:
    s_cmp_lt_u32 s13, 4
    s_cbranch_scc1 K_NOWU
    s_sub_u32 s3, s13, 4
    s_lshl_b32 s3, s3, 11
    s_add_u32 m0, s3, 146944
    s_nop 0
    buffer_load_dwordx4 v118, s[4:7], s3 offen lds
    buffer_load_dwordx4 v118, s[4:7], s3 offen offset:1024 lds
K_NOWU:
    v_lshrrev_b32 v64, 2, v162
    v_lshrrev_b32 v65, 1, v64
    v_and_b32 v66, 3, v1
    v_lshlrev_b32 v66, 3, v66
    v_lshl_add_u32 v66, v65, 6, v66
    v_lshl_add_u32 v66, v64, 7, v66
    v_lshrrev_b32 v67, 5, v1
    v_lshl_add_u32 v67, v67, 10, v66
    v_and_b32 v68, 1, v163
    v_lshl_add_u32 v67, v68, 5, v67
    v_add_u32 v67, 78336, v67
    v_xor_b32 v68, 64, v67
    v_lshl_add_u32 v69, v163, 10, v66
    s_lshl_b32 s3, s34, 5
    v_xor_b32 v166, s3, v69
    v_add_u32 v69, 78336, v166
    ds_read_b64_tr_b16 v[104:105], v69 offset:8192
    ds_read_b64_tr_b16 v[106:107], v69 offset:8704
    ds_read_b64_tr_b16 v[108:109], v69 offset:12288
    ds_read_b64_tr_b16 v[110:111], v69 offset:12800
    s_lshl_b32 s3, s33, 11
    v_add_u32 v70, s3, v164
    v_xor_b32 v71, 64, v70
    v_xor_b32 v72, 64, v164
    ds_read_b128 v[60:63], v70
    ds_read_b128 v[112:115], v164 offset:6144
    ds_read_b128 v[80:83], v71
    ds_read_b128 v[116:119], v72 offset:6144
    ds_read_b64_tr_b16 v[120:121], v67 offset:0
    ds_read_b64_tr_b16 v[122:123], v67 offset:512
    ds_read_b64_tr_b16 v[124:125], v68 offset:0
    ds_read_b64_tr_b16 v[126:127], v68 offset:512
    ds_read_b64_tr_b16 v[128:129], v67 offset:2048
    ds_read_b64_tr_b16 v[130:131], v67 offset:2560
    ds_read_b64_tr_b16 v[132:133], v68 offset:2048
    ds_read_b64_tr_b16 v[134:135], v68 offset:2560
    ds_read_b64_tr_b16 v[136:137], v67 offset:4096
    ds_read_b64_tr_b16 v[138:139], v67 offset:4608
    ds_read_b64_tr_b16 v[140:141], v68 offset:4096
    ds_read_b64_tr_b16 v[142:143], v68 offset:4608
    ds_read_b64_tr_b16 v[144:145], v67 offset:6144
    ds_read_b64_tr_b16 v[146:147], v67 offset:6656
    ds_read_b64_tr_b16 v[148:149], v68 offset:6144
    ds_read_b64_tr_b16 v[150:151], v68 offset:6656
    ds_read_b64_tr_b16 v[152:153], v67 offset:16384
    ds_read_b64_tr_b16 v[154:155], v67 offset:16896
    ds_read_b64_tr_b16 v[156:157], v68 offset:16384
    ds_read_b64_tr_b16 v[158:159], v68 offset:16896
    v_mul_u32_u24 v73, 3072, v163
    v_lshl_add_u32 v73, v162, 3, v73
    s_and_b32 s40, s34, 1
    s_lshl_b32 s40, s40, 7
    s_lshr_b32 s41, s34, 1
    s_lshl_b32 s41, s41, 2
    s_add_u32 s40, s40, s41
    s_add_u32 s40, s40, 38400
    v_add_u32 v74, s40, v73
    s_mul_i32 s41, s33, 12288
    v_add_u32 v73, s41, v74
    v_cmp_gt_u32 vcc, 16, v1
    s_waitcnt lgkmcnt(0)
    v_mfma_f32_16x16x32_bf16 v[88:91], v[60:63], v[104:107], 0
    v_mfma_f32_16x16x32_bf16 v[92:95], v[112:115], v[104:107], 0
    v_mfma_f32_16x16x32_bf16 v[88:91], v[80:83], v[108:111], v[88:91]
    v_mfma_f32_16x16x32_bf16 v[92:95], v[116:119], v[108:111], v[92:95]
    s_nop 7
    v_cvt_pk_bf16_f32 v96, v88, v88
    v_lshlrev_b32 v75, 16, v96
    v_sub_f32 v75, v88, v75
    v_cvt_pk_bf16_f32 v96, v88, v75
    v_cvt_pk_bf16_f32 v97, v89, v89
    v_lshlrev_b32 v75, 16, v97
    v_sub_f32 v75, v89, v75
    v_cvt_pk_bf16_f32 v97, v89, v75
    v_cvt_pk_bf16_f32 v98, v90, v90
    v_lshlrev_b32 v75, 16, v98
    v_sub_f32 v75, v90, v75
    v_cvt_pk_bf16_f32 v98, v90, v75
    v_cvt_pk_bf16_f32 v99, v91, v91
    v_lshlrev_b32 v75, 16, v99
    v_sub_f32 v75, v91, v75
    v_cvt_pk_bf16_f32 v99, v91, v75
    v_cvt_pk_bf16_f32 v100, v92, v92
    v_lshlrev_b32 v75, 16, v100
    v_sub_f32 v75, v92, v75
    v_cvt_pk_bf16_f32 v100, v92, v75
    v_cvt_pk_bf16_f32 v101, v93, v93
    v_lshlrev_b32 v75, 16, v101
    v_sub_f32 v75, v93, v75
    v_cvt_pk_bf16_f32 v101, v93, v75
    v_cvt_pk_bf16_f32 v102, v94, v94
    v_lshlrev_b32 v75, 16, v102
    v_sub_f32 v75, v94, v75
    v_cvt_pk_bf16_f32 v102, v94, v75
    v_cvt_pk_bf16_f32 v103, v95, v95
    v_lshlrev_b32 v75, 16, v103
    v_sub_f32 v75, v95, v75
    v_cvt_pk_bf16_f32 v103, v95, v75
    ds_write_b32 v73, v96 offset:512
    ds_write_b32 v73, v97 offset:1280
    ds_write_b32 v73, v98 offset:2048
    ds_write_b32 v73, v99 offset:2816
    s_and_saveexec_b64 s[40:41], vcc
    ds_write_b32 v74, v100 offset:37376
    ds_write_b32 v74, v101 offset:38144
    ds_write_b32 v74, v102 offset:38912
    ds_write_b32 v74, v103 offset:39680
    s_mov_b64 exec, s[40:41]
    s_lshl_b32 s35, s13, 8
    s_add_u32 s35, s35, 3072
    s_mov_b32 s100, 200000
K_ROUND:
    s_cmp_ge_u32 s13, 3
    s_cbranch_scc1 K_NOPF
    v_lshlrev_b32 v68, 4, v0
    v_mov_b32 v76, 2466265088
    v_mov_b32 v77, v76
    v_mov_b32 v78, v76
    v_mov_b32 v79, v76
    ds_write_b128 v68, v[76:79] offset:0
    v_and_b32 v69, 7, v1
    v_lshlrev_b32 v69, 2, v69
    v_add_u32 v69, 23552, v69
    v_mov_b32 v70, 2147483520
    ds_write2st64_b32 v69, v70, v70 offset0:0 offset1:57
K_NOPF:
    s_mov_b32 s39, 36
    s_mov_b32 s38, 0
    v_lshlrev_b32 v22, 11, v160
    v_cmp_gt_u32 vcc, 250, v160
    v_mul_u32_u24 v165, 3200, v160
    v_mov_b32 v106, 0x7ffffff0
    s_mov_b64 s[36:37], vcc
    s_mov_b64 exec, vcc
K_POLL:
    buffer_load_dwordx2 v[24:25], v22, s[24:27], s14 offen sc1
K_POLLW:
    s_waitcnt vmcnt(0)
    v_xor_b32 v24, s98, v24
    v_xor_b32 v25, s99, v25
    v_lshrrev_b32 v102, 24, v24
    v_or_b32 v102, v102, v25
    v_cmp_ne_u32 vcc, 0, v102
    s_cbranch_vccz K_POLLD
    s_mov_b64 exec, vcc
    s_sub_u32 s100, s100, 1
    s_cmp_lt_i32 s100, 1
    s_cbranch_scc0 K_POLL
K_POLLD:
    s_mov_b64 exec, -1
    s_andn2_b64 vcc, s[36:37], vcc
    s_mov_b32 s3, 524288
    v_cndmask_b32 v104, 0, v24, vcc
    v_lshrrev_b32 v15, 12, v104
    v_and_b32 v104, 0xfff, v104
    v_subrev_u32 v15, s15, v15
    v_add3_u32 v104, v104, v165, v161
    v_add_lshl_u32 v104, v104, s15, 2
    v_sub_u32 v107, v15, v161
    v_cmp_lt_i32 vcc, 0, v107
    v_cmp_lt_i32 s[40:41], 12, v107
    v_cmp_lt_i32 s[36:37], 24, v107
    v_cndmask_b32 v108, v106, v104, vcc
    v_cndmask_b32 v109, v106, v104, s[40:41]
    buffer_load_dwordx4 v[36:39], v108, s[24:27], s3 offen sc1
    v_cndmask_b32 v110, v106, v104, s[36:37]
    buffer_load_dwordx4 v[40:43], v109, s[24:27], s3 offen offset:48 sc1
    buffer_load_dwordx4 v[44:47], v110, s[24:27], s3 offen offset:96 sc1
    v_lshlrev_b32 v165, 5, v165
K_MASKS:
    v_lshl_add_u32 v96, v1, 2, s35
    v_mov_b32 v97, 0
    ds_write_b32 v96, v97
    v_min_i32 v107, s39, v15
    v_sub_u32 v107, v107, v161
    v_mov_b32 v98, 1
    v_mov_b32 v99, s35
    v_cmp_lt_i32 s[40:41], s39, v15
    v_cmp_lt_i32 s[44:45], 0, v107
    v_cmp_lt_i32 s[46:47], 1, v107
    v_cmp_lt_i32 s[48:49], 2, v107
    v_cmp_lt_i32 s[50:51], 3, v107
    v_cmp_lt_i32 s[52:53], 12, v107
    v_cmp_lt_i32 s[54:55], 13, v107
    v_cmp_lt_i32 s[56:57], 14, v107
    v_cmp_lt_i32 s[58:59], 15, v107
    v_cmp_lt_i32 s[60:61], 24, v107
    v_cmp_lt_i32 s[62:63], 25, v107
    v_cmp_lt_i32 s[64:65], 26, v107
    v_cmp_lt_i32 s[66:67], 27, v107
    s_cmp_lg_u32 s38, 0
    s_cbranch_scc1 K_CNT2
    s_waitcnt vmcnt(0)
    s_mov_b64 exec, s[44:45]
    v_bfe_u32 v60, v36, 12, 6
    v_lshl_add_u32 v60, v60, 2, v99
    ds_add_rtn_u32 v72, v60, v98
    s_mov_b64 exec, s[46:47]
    v_bfe_u32 v61, v37, 12, 6
    v_lshl_add_u32 v61, v61, 2, v99
    ds_add_rtn_u32 v73, v61, v98
    s_mov_b64 exec, s[48:49]
    v_bfe_u32 v62, v38, 12, 6
    v_lshl_add_u32 v62, v62, 2, v99
    ds_add_rtn_u32 v74, v62, v98
    s_mov_b64 exec, s[50:51]
    v_bfe_u32 v63, v39, 12, 6
    v_lshl_add_u32 v63, v63, 2, v99
    ds_add_rtn_u32 v75, v63, v98
    s_mov_b64 exec, s[52:53]
    v_bfe_u32 v64, v40, 12, 6
    v_lshl_add_u32 v64, v64, 2, v99
    ds_add_rtn_u32 v76, v64, v98
    s_mov_b64 exec, s[54:55]
    v_bfe_u32 v65, v41, 12, 6
    v_lshl_add_u32 v65, v65, 2, v99
    ds_add_rtn_u32 v77, v65, v98
    s_mov_b64 exec, s[56:57]
    v_bfe_u32 v66, v42, 12, 6
    v_lshl_add_u32 v66, v66, 2, v99
    ds_add_rtn_u32 v78, v66, v98
    s_mov_b64 exec, s[58:59]
    v_bfe_u32 v67, v43, 12, 6
    v_lshl_add_u32 v67, v67, 2, v99
    ds_add_rtn_u32 v79, v67, v98
    s_cmp_eq_u64 s[60:61], 0
    s_cbranch_scc1 K_C0
    s_mov_b64 exec, s[60:61]
    v_bfe_u32 v68, v44, 12, 6
    v_lshl_add_u32 v68, v68, 2, v99
    ds_add_rtn_u32 v80, v68, v98
    s_mov_b64 exec, s[62:63]
    v_bfe_u32 v69, v45, 12, 6
    v_lshl_add_u32 v69, v69, 2, v99
    ds_add_rtn_u32 v81, v69, v98
    s_mov_b64 exec, s[64:65]
    v_bfe_u32 v70, v46, 12, 6
    v_lshl_add_u32 v70, v70, 2, v99
    ds_add_rtn_u32 v82, v70, v98
    s_mov_b64 exec, s[66:67]
    v_bfe_u32 v71, v47, 12, 6
    v_lshl_add_u32 v71, v71, 2, v99
    ds_add_rtn_u32 v83, v71, v98
K_C0:
    s_branch K_CNTD
K_CNT2:
    s_mov_b64 exec, s[44:45]
    ds_add_rtn_u32 v72, v60, v98
    s_mov_b64 exec, s[46:47]
    ds_add_rtn_u32 v73, v61, v98
    s_mov_b64 exec, s[48:49]
    ds_add_rtn_u32 v74, v62, v98
    s_mov_b64 exec, s[50:51]
    ds_add_rtn_u32 v75, v63, v98
K_CNTD:
    s_mov_b64 exec, s[40:41]
    ds_add_u32 v99, v98 offset:252
    s_mov_b64 exec, -1
    s_cmp_lg_u32 s38, 0
    s_cbranch_scc1 K_NOUNP
    v_lshrrev_b32 v48, 11, v36
    v_and_b32 v48, 0xffffff80, v48
    v_and_b32 v36, 0xfff, v36
    v_lshl_add_u32 v36, v36, 5, v165
    v_lshrrev_b32 v49, 11, v37
    v_and_b32 v49, 0xffffff80, v49
    v_and_b32 v37, 0xfff, v37
    v_lshl_add_u32 v37, v37, 5, v165
    v_lshrrev_b32 v50, 11, v38
    v_and_b32 v50, 0xffffff80, v50
    v_and_b32 v38, 0xfff, v38
    v_lshl_add_u32 v38, v38, 5, v165
    v_lshrrev_b32 v51, 11, v39
    v_and_b32 v51, 0xffffff80, v51
    v_and_b32 v39, 0xfff, v39
    v_lshl_add_u32 v39, v39, 5, v165
    v_lshrrev_b32 v52, 11, v40
    v_and_b32 v52, 0xffffff80, v52
    v_and_b32 v40, 0xfff, v40
    v_lshl_add_u32 v40, v40, 5, v165
    v_lshrrev_b32 v53, 11, v41
    v_and_b32 v53, 0xffffff80, v53
    v_and_b32 v41, 0xfff, v41
    v_lshl_add_u32 v41, v41, 5, v165
    v_lshrrev_b32 v54, 11, v42
    v_and_b32 v54, 0xffffff80, v54
    v_and_b32 v42, 0xfff, v42
    v_lshl_add_u32 v42, v42, 5, v165
    v_lshrrev_b32 v55, 11, v43
    v_and_b32 v55, 0xffffff80, v55
    v_and_b32 v43, 0xfff, v43
    v_lshl_add_u32 v43, v43, 5, v165
    s_cmp_eq_u64 s[60:61], 0
    s_cbranch_scc1 K_C2
    v_lshrrev_b32 v56, 11, v44
    v_and_b32 v56, 0xffffff80, v56
    v_and_b32 v44, 0xfff, v44
    v_lshl_add_u32 v44, v44, 5, v165
    v_lshrrev_b32 v57, 11, v45
    v_and_b32 v57, 0xffffff80, v57
    v_and_b32 v45, 0xfff, v45
    v_lshl_add_u32 v45, v45, 5, v165
    v_lshrrev_b32 v58, 11, v46
    v_and_b32 v58, 0xffffff80, v58
    v_and_b32 v46, 0xfff, v46
    v_lshl_add_u32 v46, v46, 5, v165
    v_lshrrev_b32 v59, 11, v47
    v_and_b32 v59, 0xffffff80, v59
    v_and_b32 v47, 0xfff, v47
    v_lshl_add_u32 v47, v47, 5, v165
K_C2:
K_NOUNP:
    v_lshlrev_b32 v96, 2, v1
    s_waitcnt lgkmcnt(0)
    s_barrier
    s_cmp_ge_u32 s13, 2
    s_cbranch_scc1 K_NOEPF
    v_mov_b32 v99, 0x7ffffff0
    v_cndmask_b32 v101, v99, v36, s[44:45]
    buffer_load_dword v119, v101, s[20:23], 0 offen
    v_cndmask_b32 v101, v99, v37, s[46:47]
    buffer_load_dword v119, v101, s[20:23], 0 offen
K_NOEPF:
    ds_read2st64_b32 v[102:103], v96 offset0:12 offset1:13
    ds_read2st64_b32 v[104:105], v96 offset0:14 offset1:15
    ds_read2st64_b32 v[106:107], v96 offset0:16 offset1:17
    ds_read2st64_b32 v[108:109], v96 offset0:18 offset1:19
    ds_read2st64_b32 v[110:111], v96 offset0:20 offset1:21
    ds_read2st64_b32 v[112:113], v96 offset0:22 offset1:23
    v_mov_b32 v101, 0
    v_cmp_gt_u32 vcc, 63, v1
    v_mul_u32_u24 v97, 768, v1
    v_lshlrev_b32 v97, 16, v97
    v_add_u32 v98, s35, v96
    s_waitcnt lgkmcnt(0)
    v_add_u32 v103, v102, v103
    v_add_u32 v104, v103, v104
    v_add_u32 v105, v104, v105
    v_add_u32 v106, v105, v106
    v_add_u32 v107, v106, v107
    v_add_u32 v108, v107, v108
    v_add_u32 v109, v108, v109
    v_add_u32 v110, v109, v110
    v_add_u32 v111, v110, v111
    v_add_u32 v112, v111, v112
    v_add_u32 v113, v112, v113
    s_set_gpr_idx_on s13, gpr_idx(SRC0)
    s_nop 0
    v_mov_b32 v115, v101
    v_mov_b32 v117, v102
    s_set_gpr_idx_off
    s_cmp_eq_u32 s13, 11
    s_cselect_b32 s3, 7, 3
    v_readlane_b32 s36, v113, 63
    v_cndmask_b32 v113, 0, v113, vcc
    v_cndmask_b32 v115, 0, v115, vcc
    v_cndmask_b32 v106, 0, v117, vcc
    v_add_u32 v114, 7, v113
    v_lshrrev_b32 v114, 3, v114
    v_add_u32 v104, 3, v115
    v_lshrrev_b32 v104, 3, v104
    v_add_u32 v105, s3, v106
    v_lshrrev_b32 v105, 3, v105
    v_sub_u32 v105, v105, v104
    v_lshl_or_b32 v116, v104, 10, v105
    v_lshl_or_b32 v116, v114, 21, v116
    v_lshlrev_b32 v167, 3, v114
    v_sub_u32 v167, v167, v113
    v_add_u32_dpp v116, v116, v116 row_shr:1 row_mask:0xf bank_mask:0xf bound_ctrl:0
    v_mov_b32 v103, 2147483520
    v_cmp_lt_u32 vcc, 0, v105
    v_add_u32_dpp v116, v116, v116 row_shr:2 row_mask:0xf bank_mask:0xf bound_ctrl:0
    v_cmp_lt_u32 s[40:41], s13, v167
    v_add_u32 v113, s13, v113
    v_add_u32_dpp v116, v116, v116 row_shr:4 row_mask:0xf bank_mask:0xf bound_ctrl:0
    s_nop 1
    v_add_u32_dpp v116, v116, v116 row_shr:8 row_mask:0xf bank_mask:0xf bound_ctrl:0
    s_nop 1
    v_add_u32_dpp v116, v116, v116 row_bcast:15 row_mask:0xa bank_mask:0xf
    s_nop 1
    v_add_u32_dpp v116, v116, v116 row_bcast:31 row_mask:0xc bank_mask:0xf
    v_lshrrev_b32 v118, 21, v116
    v_readlane_b32 s37, v116, 63
    v_sub_u32 v118, v118, v114
    v_lshl_add_u32 v115, v118, 3, v115
    v_lshlrev_b32 v115, 2, v115
    s_bfe_u32 s3, s37, 0xb000a
    s_lshr_b32 s37, s37, 21
    s_cmp_le_u32 s37, 448
    s_cbranch_scc1 K_FIT
    s_cmp_lg_u32 s38, 0
    s_cbranch_scc1 K_FIT
    s_mov_b32 s38, 1
    s_mov_b32 s39, 12
    s_barrier
    s_branch K_MASKS
K_FIT:
    ds_write_b32 v98, v115 offset:3072
    s_mov_b64 exec, s[44:45]
    ds_read_b32 v84, v60 offset:3072
    s_mov_b64 exec, s[46:47]
    ds_read_b32 v85, v61 offset:3072
    s_mov_b64 exec, s[48:49]
    ds_read_b32 v86, v62 offset:3072
    s_mov_b64 exec, s[50:51]
    ds_read_b32 v87, v63 offset:3072
    s_mov_b64 exec, s[52:53]
    ds_read_b32 v88, v64 offset:3072
    s_mov_b64 exec, s[54:55]
    ds_read_b32 v89, v65 offset:3072
    s_mov_b64 exec, s[56:57]
    ds_read_b32 v90, v66 offset:3072
    s_mov_b64 exec, s[58:59]
    ds_read_b32 v91, v67 offset:3072
    s_cmp_eq_u64 s[60:61], 0
    s_cbranch_scc1 K_C3
    s_mov_b64 exec, s[60:61]
    ds_read_b32 v92, v68 offset:3072
    s_mov_b64 exec, s[62:63]
    ds_read_b32 v93, v69 offset:3072
    s_mov_b64 exec, s[64:65]
    ds_read_b32 v94, v70 offset:3072
    s_mov_b64 exec, s[66:67]
    ds_read_b32 v95, v71 offset:3072
K_C3:
    s_mov_b64 exec, s[40:41]
    v_lshl_add_u32 v102, v118, 3, v113
    v_lshlrev_b32 v102, 2, v102
    ds_write2st64_b32 v102, v103, v103 offset0:36 offset1:93
    s_mov_b64 exec, -1
    v_and_b32 v99, 0x3ff, v116
    v_sub_u32 v99, v99, v105
    v_add_lshl_u32 v99, v99, s3, 2
    v_add_u32 v117, v104, v118
    v_lshl_or_b32 v117, v117, 5, v97
    s_mov_b32 s43, 1
K_PL:
    s_mov_b64 exec, vcc
    ds_write_b32 v99, v117 offset:0
    v_cmp_lt_u32 vcc, s43, v105
    v_add_u32 v99, 4, v99
    v_add_u32 v117, 32, v117
    s_add_u32 s43, s43, 1
    s_cbranch_vccnz K_PL
    s_waitcnt lgkmcnt(0)
    s_mov_b64 exec, s[44:45]
    v_lshl_add_u32 v84, v72, 2, v84
    ds_write2st64_b32 v84, v48, v36 offset0:36 offset1:93
    s_mov_b64 exec, s[46:47]
    v_lshl_add_u32 v85, v73, 2, v85
    ds_write2st64_b32 v85, v49, v37 offset0:36 offset1:93
    s_mov_b64 exec, s[48:49]
    v_lshl_add_u32 v86, v74, 2, v86
    ds_write2st64_b32 v86, v50, v38 offset0:36 offset1:93
    s_mov_b64 exec, s[50:51]
    v_lshl_add_u32 v87, v75, 2, v87
    ds_write2st64_b32 v87, v51, v39 offset0:36 offset1:93
    s_mov_b64 exec, s[52:53]
    v_lshl_add_u32 v88, v76, 2, v88
    ds_write2st64_b32 v88, v52, v40 offset0:36 offset1:93
    s_mov_b64 exec, s[54:55]
    v_lshl_add_u32 v89, v77, 2, v89
    ds_write2st64_b32 v89, v53, v41 offset0:36 offset1:93
    s_mov_b64 exec, s[56:57]
    v_lshl_add_u32 v90, v78, 2, v90
    ds_write2st64_b32 v90, v54, v42 offset0:36 offset1:93
    s_mov_b64 exec, s[58:59]
    v_lshl_add_u32 v91, v79, 2, v91
    ds_write2st64_b32 v91, v55, v43 offset0:36 offset1:93
    s_cmp_eq_u64 s[60:61], 0
    s_cbranch_scc1 K_C4
    s_mov_b64 exec, s[60:61]
    v_lshl_add_u32 v92, v80, 2, v92
    ds_write2st64_b32 v92, v56, v44 offset0:36 offset1:93
    s_mov_b64 exec, s[62:63]
    v_lshl_add_u32 v93, v81, 2, v93
    ds_write2st64_b32 v93, v57, v45 offset0:36 offset1:93
    s_mov_b64 exec, s[64:65]
    v_lshl_add_u32 v94, v82, 2, v94
    ds_write2st64_b32 v94, v58, v46 offset0:36 offset1:93
    s_mov_b64 exec, s[66:67]
    v_lshl_add_u32 v95, v83, 2, v95
    ds_write2st64_b32 v95, v59, v47 offset0:36 offset1:93
K_C4:
    s_mov_b64 exec, -1
    s_add_u32 s37, s37, 3
    s_lshr_b32 s37, s37, 2
    s_lshl_b32 s3, s13, 4
    s_add_u32 s3, s3, 0
    v_lshl_add_u32 v2, v163, 2, s3
    v_lshrrev_b32 v97, 5, v1
    v_lshl_add_u32 v3, v97, 3, s3
    s_mov_b32 s60, s32
    s_add_u32 s61, s32, 1024
    s_add_u32 s62, s32, 2048
    s_add_u32 s63, s32, 3072
    s_add_u32 s64, s32, 4096
    s_mov_b32 s65, s13
    s_waitcnt lgkmcnt(0)
    s_barrier
    s_cmp_ge_u32 s65, s37
    s_cbranch_scc1 K_CORR
    ds_read_b32 v14, v2
    ds_read_b64 v[16:17], v3
    s_waitcnt lgkmcnt(0)
    v_add_u32_sdwa v22, v14, v4 dst_sel:DWORD dst_unused:UNUSED_PAD src0_sel:WORD_0 src1_sel:DWORD
    v_add_u32_sdwa v23, v14, v5 dst_sel:DWORD dst_unused:UNUSED_PAD src0_sel:WORD_0 src1_sel:DWORD
    ds_read_b128 v[24:27], v22
    ds_read_b32 v15, v23
    v_add_u32_sdwa v20, v16, v6 dst_sel:DWORD dst_unused:UNUSED_PAD src0_sel:WORD_1 src1_sel:DWORD
    v_add_u32_sdwa v21, v17, v6 dst_sel:DWORD dst_unused:UNUSED_PAD src0_sel:WORD_1 src1_sel:DWORD
    ds_read_b32 v14, v2 offset:192
    ds_read_b64 v[16:17], v3 offset:192
    s_waitcnt lgkmcnt(0)
    s_cmp_ge_u32 s65, s37
    s_cbranch_scc1 K_IL0
    s_mov_b32 m0, s60
    v_xad_u32 v24, v7, 0, v24
    buffer_load_dwordx4 v24, s[16:19], 0 offen lds
    s_mov_b32 m0, s61
    v_xad_u32 v25, v7, 16, v25
    buffer_load_dwordx4 v25, s[16:19], 0 offen lds
    s_mov_b32 m0, s62
    v_xad_u32 v26, v7, 32, v26
    buffer_load_dwordx4 v26, s[16:19], 0 offen lds
    s_mov_b32 m0, s63
    v_xad_u32 v27, v7, 48, v27
    buffer_load_dwordx4 v27, s[16:19], 0 offen lds
    s_mov_b32 m0, s64
    v_add_u32 v15, v15, v8
    buffer_load_dwordx4 v15, s[20:23], 0 offen lds
K_IL0:
    s_add_u32 s65, s65, 12
    v_add_u32_sdwa v22, v14, v4 dst_sel:DWORD dst_unused:UNUSED_PAD src0_sel:WORD_0 src1_sel:DWORD
    v_add_u32_sdwa v23, v14, v5 dst_sel:DWORD dst_unused:UNUSED_PAD src0_sel:WORD_0 src1_sel:DWORD
    ds_read_b128 v[24:27], v22
    ds_read_b32 v15, v23
    ds_read_b32 v14, v2 offset:384
    v_add_u32 v2, 576, v2
    v_add_u32 v3, 384, v3
K_CORR:
    v_and_b32 v64, 31, v1
    v_lshlrev_b32 v64, 3, v64
    v_lshrrev_b32 v65, 5, v1
    v_lshl_add_u32 v64, v65, 2, v64
    s_mul_i32 s3, s13, 768
    s_add_u32 s3, s3, 38400
    v_add_u32 v64, s3, v64
    v_lshl_add_u32 v65, v1, 3, s3
    v_cvt_f32_u32 v66, v167
    v_mul_f32 v66, 0xce800000, v66
    s_mov_b32 s47, 0xffff0000
    ds_read_b32 v88, v64 offset:512
    ds_read_b32 v89, v64 offset:9728
    ds_read_b32 v90, v64 offset:18944
    ds_read_b32 v91, v64 offset:28160
    ds_read_b32 v92, v64 offset:37376
    s_add_u32 s3, s13, 0
    s_nop 0
    v_readlane_b32 s53, v66, s3
    s_add_u32 s3, s13, 12
    s_nop 0
    v_readlane_b32 s54, v66, s3
    s_add_u32 s3, s13, 24
    s_nop 0
    v_readlane_b32 s55, v66, s3
    s_add_u32 s3, s13, 36
    s_nop 0
    v_readlane_b32 s56, v66, s3
    s_add_u32 s3, s13, 48
    s_nop 0
    v_readlane_b32 s57, v66, s3
    s_waitcnt lgkmcnt(0)
    v_lshlrev_b32 v93, 16, v88
    v_and_b32 v88, s47, v88
    v_add_f32 v88, v88, v93
    v_lshlrev_b32 v94, 16, v89
    v_and_b32 v89, s47, v89
    v_add_f32 v89, v89, v94
    v_lshlrev_b32 v95, 16, v90
    v_and_b32 v90, s47, v90
    v_add_f32 v90, v90, v95
    v_lshlrev_b32 v96, 16, v91
    v_and_b32 v91, s47, v91
    v_add_f32 v91, v91, v96
    v_lshlrev_b32 v97, 16, v92
    v_and_b32 v92, s47, v92
    v_add_f32 v92, v92, v97
    v_mul_f32 v93, s70, v88
    v_mul_f32 v94, s70, v89
    v_mul_f32 v95, s70, v90
    v_mul_f32 v96, s70, v91
    v_mul_f32 v97, s70, v92
    v_exp_f32 v93, v93
    v_exp_f32 v94, v94
    v_exp_f32 v95, v95
    v_exp_f32 v96, v96
    v_exp_f32 v97, v97
    v_add_f32 v93, 1.0, v93
    v_add_f32 v94, 1.0, v94
    v_add_f32 v95, 1.0, v95
    v_add_f32 v96, 1.0, v96
    v_add_f32 v97, 1.0, v97
    v_rcp_f32 v93, v93
    v_rcp_f32 v94, v94
    v_rcp_f32 v95, v95
    v_rcp_f32 v96, v96
    v_rcp_f32 v97, v97
    v_mul_f32 v88, s53, v88
    v_mul_f32 v89, s54, v89
    v_mul_f32 v90, s55, v90
    v_mul_f32 v91, s56, v91
    v_mul_f32 v92, s57, v92
    v_mul_f32 v88, v88, v93
    v_mul_f32 v89, v89, v94
    v_mul_f32 v90, v90, v95
    v_mul_f32 v91, v91, v96
    v_mul_f32 v92, v92, v97
    v_cvt_f64_f32 v[104:105], v88
    v_cvt_f64_f32 v[106:107], v89
    v_cvt_f64_f32 v[108:109], v90
    v_cvt_f64_f32 v[110:111], v91
    v_cvt_f64_f32 v[112:113], v92
    ds_add_f64 v65, v[104:105] offset:0
    ds_add_f64 v65, v[106:107] offset:9216
    ds_add_f64 v65, v[108:109] offset:18432
    ds_add_f64 v65, v[110:111] offset:27648
    s_cmp_lg_u32 s13, 0
    s_cbranch_scc1 K_CORR2
    ds_add_f64 v65, v[112:113] offset:36864
K_CORR2:
    s_cmp_ge_u32 s13, s37
    s_cbranch_scc1 K_LOOPEND
    v_mov_b32 v56, 0
    v_mov_b32 v57, 0
    v_mov_b32 v58, 1.0
    v_mov_b32 v59, 1.0
    v_mov_b32 v60, 0
    v_mov_b32 v61, 0
    v_mov_b32 v62, 1.0
    v_mov_b32 v63, 1.0
    v_mov_b32 v18, v20
    v_mov_b32 v19, v21
    s_mov_b32 s66, s13
    s_waitcnt vmcnt(0)
    ds_read_b128 v[52:55], v13
    ds_read_b32 v28, v20 offset:512
    ds_read_b32 v29, v21 offset:512
    ds_read_b32 v30, v20 offset:516
    ds_read_b32 v31, v21 offset:516
    ds_read_b128 v[36:39], v9
    ds_read_b128 v[40:43], v10
    ds_read_b128 v[44:47], v11
    ds_read_b128 v[48:51], v12
    s_waitcnt lgkmcnt(0)
    s_cmp_ge_u32 s65, s37
    s_cbranch_scc1 K_IL1
    s_mov_b32 m0, s60
    v_xad_u32 v24, v7, 0, v24
    buffer_load_dwordx4 v24, s[16:19], 0 offen lds
    s_mov_b32 m0, s61
    v_xad_u32 v25, v7, 16, v25
    buffer_load_dwordx4 v25, s[16:19], 0 offen lds
    s_mov_b32 m0, s62
    v_xad_u32 v26, v7, 32, v26
    buffer_load_dwordx4 v26, s[16:19], 0 offen lds
    s_mov_b32 m0, s63
    v_xad_u32 v27, v7, 48, v27
    buffer_load_dwordx4 v27, s[16:19], 0 offen lds
    s_mov_b32 m0, s64
    v_add_u32 v15, v15, v8
    buffer_load_dwordx4 v15, s[20:23], 0 offen lds
K_IL1:
    s_add_u32 s65, s65, 12
    v_mfma_f32_32x32x16_bf16 v[88:103], v[52:55], v[152:155], 0
    v_mfma_f32_32x32x16_bf16 v[88:103], v[32:35], v[28:31], v[88:103]
    v_mfma_f32_32x32x16_bf16 v[88:103], v[36:39], v[120:123], v[88:103]
    v_mfma_f32_32x32x16_bf16 v[88:103], v[40:43], v[128:131], v[88:103]
    v_mfma_f32_32x32x16_bf16 v[88:103], v[44:47], v[136:139], v[88:103]
    v_mfma_f32_32x32x16_bf16 v[88:103], v[48:51], v[144:147], v[88:103]
    s_nop 11
    v_pk_mul_f32 v[64:65], v[88:89], s[70:71]
    v_pk_mul_f32 v[66:67], v[90:91], s[70:71]
    v_pk_mul_f32 v[68:69], v[92:93], s[70:71]
    v_pk_mul_f32 v[70:71], v[94:95], s[70:71]
    v_pk_mul_f32 v[72:73], v[96:97], s[70:71]
    v_pk_mul_f32 v[74:75], v[98:99], s[70:71]
    v_pk_mul_f32 v[76:77], v[100:101], s[70:71]
    v_pk_mul_f32 v[78:79], v[102:103], s[70:71]
K_LOOP:
    s_sub_u32 s3, s37, s66
    s_cmp_gt_u32 s3, 72
    s_cbranch_scc1 K_P3
    s_cmp_gt_u32 s3, 36
    s_cbranch_scc1 K_P2
    s_cmp_gt_u32 s3, 12
    s_cbranch_scc1 K_P1
    s_setprio 0
    s_branch K_PD
K_P1:
    s_setprio 1
    s_branch K_PD
K_P2:
    s_setprio 2
    s_branch K_PD
K_P3:
    s_setprio 3
K_PD:
    v_mfma_f32_32x32x16_bf16 v[104:119], v[52:55], v[156:159], 0
    v_rcp_f32 v58, v58
    v_rcp_f32 v59, v59
    v_rcp_f32 v62, v62
    v_mfma_f32_32x32x16_bf16 v[104:119], v[32:35], v[30:33], v[104:119]
    v_rcp_f32 v63, v63
    v_exp_f32 v64, v64
    v_exp_f32 v65, v65
    v_mfma_f32_32x32x16_bf16 v[104:119], v[36:39], v[124:127], v[104:119]
    v_exp_f32 v66, v66
    v_exp_f32 v67, v67
    v_exp_f32 v68, v68
    v_mfma_f32_32x32x16_bf16 v[104:119], v[40:43], v[132:135], v[104:119]
    v_exp_f32 v69, v69
    v_exp_f32 v70, v70
    v_exp_f32 v71, v71
    v_mfma_f32_32x32x16_bf16 v[104:119], v[44:47], v[140:143], v[104:119]
    v_exp_f32 v72, v72
    v_exp_f32 v73, v73
    v_exp_f32 v74, v74
    v_mfma_f32_32x32x16_bf16 v[104:119], v[48:51], v[148:151], v[104:119]
    v_exp_f32 v75, v75
    v_exp_f32 v76, v76
    v_exp_f32 v77, v77
    v_exp_f32 v78, v78
    v_exp_f32 v79, v79
    v_mul_f32 v56, v56, v58
    v_mul_f32 v60, v60, v62
    v_fmac_f32 v56, v57, v59
    v_fmac_f32 v60, v61, v63
    v_cvt_f64_f32 v[84:85], v56
    v_cvt_f64_f32 v[86:87], v60
    ds_add_f64 v18, v[84:85] offset:256
    ds_add_f64 v19, v[86:87] offset:256
    v_mov_b32 v18, v20
    v_mov_b32 v19, v21
    v_add_u32_sdwa v20, v16, v6 dst_sel:DWORD dst_unused:UNUSED_PAD src0_sel:WORD_1 src1_sel:DWORD
    v_add_u32_sdwa v21, v17, v6 dst_sel:DWORD dst_unused:UNUSED_PAD src0_sel:WORD_1 src1_sel:DWORD
    v_add_u32_sdwa v22, v14, v4 dst_sel:DWORD dst_unused:UNUSED_PAD src0_sel:WORD_0 src1_sel:DWORD
    v_add_u32_sdwa v23, v14, v5 dst_sel:DWORD dst_unused:UNUSED_PAD src0_sel:WORD_0 src1_sel:DWORD
    ds_read_b128 v[24:27], v22
    ds_read_b32 v15, v23
    ds_read_b32 v14, v2
    ds_read_b64 v[16:17], v3
    v_add_u32 v2, 192, v2
    v_add_u32 v3, 192, v3
    s_waitcnt vmcnt(0)
    ds_read_b128 v[52:55], v13
    ds_read_b32 v28, v20 offset:512
    ds_read_b32 v29, v21 offset:512
    ds_read_b32 v30, v20 offset:516
    ds_read_b32 v31, v21 offset:516
    ds_read_b128 v[36:39], v9
    ds_read_b128 v[40:43], v10
    ds_read_b128 v[44:47], v11
    ds_read_b128 v[48:51], v12
    v_pk_fma_f32 v[64:65], v[64:65], s[96:97], s[96:97] clamp
    v_pk_fma_f32 v[66:67], v[66:67], s[96:97], s[96:97] clamp
    v_pk_fma_f32 v[68:69], v[68:69], s[96:97], s[96:97] clamp
    v_pk_fma_f32 v[70:71], v[70:71], s[96:97], s[96:97] clamp
    v_pk_fma_f32 v[72:73], v[72:73], s[96:97], s[96:97] clamp
    v_pk_fma_f32 v[74:75], v[74:75], s[96:97], s[96:97] clamp
    v_pk_fma_f32 v[76:77], v[76:77], s[96:97], s[96:97] clamp
    v_pk_fma_f32 v[78:79], v[78:79], s[96:97], s[96:97] clamp
    v_pk_mul_f32 v[80:81], v[64:65], v[66:67]
    v_pk_mul_f32 v[88:89], v[88:89], v[66:67]
    v_pk_mul_f32 v[92:93], v[92:93], v[70:71]
    v_pk_mul_f32 v[82:83], v[72:73], v[74:75]
    v_pk_mul_f32 v[96:97], v[96:97], v[74:75]
    v_pk_mul_f32 v[100:101], v[100:101], v[78:79]
    v_pk_fma_f32 v[88:89], v[90:91], v[64:65], v[88:89]
    v_pk_fma_f32 v[92:93], v[94:95], v[68:69], v[92:93]
    v_pk_mul_f32 v[90:91], v[68:69], v[70:71]
    v_pk_fma_f32 v[96:97], v[98:99], v[72:73], v[96:97]
    v_pk_fma_f32 v[100:101], v[102:103], v[76:77], v[100:101]
    v_pk_mul_f32 v[98:99], v[76:77], v[78:79]
    v_pk_mul_f32 v[88:89], v[88:89], v[90:91]
    v_pk_mul_f32 v[58:59], v[80:81], v[90:91]
    v_pk_mul_f32 v[96:97], v[96:97], v[98:99]
    v_pk_mul_f32 v[62:63], v[82:83], v[98:99]
    v_pk_fma_f32 v[56:57], v[92:93], v[80:81], v[88:89]
    v_pk_fma_f32 v[60:61], v[100:101], v[82:83], v[96:97]
    v_pk_mul_f32 v[64:65], v[104:105], s[70:71]
    v_pk_mul_f32 v[66:67], v[106:107], s[70:71]
    v_pk_mul_f32 v[68:69], v[108:109], s[70:71]
    v_pk_mul_f32 v[70:71], v[110:111], s[70:71]
    v_pk_mul_f32 v[72:73], v[112:113], s[70:71]
    v_pk_mul_f32 v[74:75], v[114:115], s[70:71]
    v_pk_mul_f32 v[76:77], v[116:117], s[70:71]
    v_pk_mul_f32 v[78:79], v[118:119], s[70:71]
    s_waitcnt lgkmcnt(0)
    s_cmp_ge_u32 s65, s37
    s_cbranch_scc1 K_IL2
    s_mov_b32 m0, s60
    v_xad_u32 v24, v7, 0, v24
    buffer_load_dwordx4 v24, s[16:19], 0 offen lds
    s_mov_b32 m0, s61
    v_xad_u32 v25, v7, 16, v25
    buffer_load_dwordx4 v25, s[16:19], 0 offen lds
    s_mov_b32 m0, s62
    v_xad_u32 v26, v7, 32, v26
    buffer_load_dwordx4 v26, s[16:19], 0 offen lds
    s_mov_b32 m0, s63
    v_xad_u32 v27, v7, 48, v27
    buffer_load_dwordx4 v27, s[16:19], 0 offen lds
    s_mov_b32 m0, s64
    v_add_u32 v15, v15, v8
    buffer_load_dwordx4 v15, s[20:23], 0 offen lds
K_IL2:
    s_add_u32 s65, s65, 12
    v_mfma_f32_32x32x16_bf16 v[88:103], v[52:55], v[152:155], 0
    v_rcp_f32 v58, v58
    v_rcp_f32 v59, v59
    v_rcp_f32 v62, v62
    v_mfma_f32_32x32x16_bf16 v[88:103], v[32:35], v[28:31], v[88:103]
    v_rcp_f32 v63, v63
    v_exp_f32 v64, v64
    v_exp_f32 v65, v65
    v_mfma_f32_32x32x16_bf16 v[88:103], v[36:39], v[120:123], v[88:103]
    v_exp_f32 v66, v66
    v_exp_f32 v67, v67
    v_exp_f32 v68, v68
    v_mfma_f32_32x32x16_bf16 v[88:103], v[40:43], v[128:131], v[88:103]
    v_exp_f32 v69, v69
    v_exp_f32 v70, v70
    v_exp_f32 v71, v71
    v_mfma_f32_32x32x16_bf16 v[88:103], v[44:47], v[136:139], v[88:103]
    v_exp_f32 v72, v72
    v_exp_f32 v73, v73
    v_exp_f32 v74, v74
    v_mfma_f32_32x32x16_bf16 v[88:103], v[48:51], v[144:147], v[88:103]
    v_exp_f32 v75, v75
    v_exp_f32 v76, v76
    v_exp_f32 v77, v77
    v_exp_f32 v78, v78
    v_exp_f32 v79, v79
    v_mul_f32 v56, v56, v58
    v_mul_f32 v60, v60, v62
    v_fmac_f32 v56, v57, v59
    v_fmac_f32 v60, v61, v63
    v_cvt_f64_f32 v[84:85], v56
    v_cvt_f64_f32 v[86:87], v60
    ds_add_f64 v18, v[84:85] offset:0
    ds_add_f64 v19, v[86:87] offset:0
    v_pk_fma_f32 v[64:65], v[64:65], s[96:97], s[96:97] clamp
    v_pk_fma_f32 v[66:67], v[66:67], s[96:97], s[96:97] clamp
    v_pk_fma_f32 v[68:69], v[68:69], s[96:97], s[96:97] clamp
    v_pk_fma_f32 v[70:71], v[70:71], s[96:97], s[96:97] clamp
    v_pk_fma_f32 v[72:73], v[72:73], s[96:97], s[96:97] clamp
    v_pk_fma_f32 v[74:75], v[74:75], s[96:97], s[96:97] clamp
    v_pk_fma_f32 v[76:77], v[76:77], s[96:97], s[96:97] clamp
    v_pk_fma_f32 v[78:79], v[78:79], s[96:97], s[96:97] clamp
    v_pk_mul_f32 v[80:81], v[64:65], v[66:67]
    v_pk_mul_f32 v[104:105], v[104:105], v[66:67]
    v_pk_mul_f32 v[108:109], v[108:109], v[70:71]
    v_pk_mul_f32 v[82:83], v[72:73], v[74:75]
    v_pk_mul_f32 v[112:113], v[112:113], v[74:75]
    v_pk_mul_f32 v[116:117], v[116:117], v[78:79]
    v_pk_fma_f32 v[104:105], v[106:107], v[64:65], v[104:105]
    v_pk_fma_f32 v[108:109], v[110:111], v[68:69], v[108:109]
    v_pk_mul_f32 v[106:107], v[68:69], v[70:71]
    v_pk_fma_f32 v[112:113], v[114:115], v[72:73], v[112:113]
    v_pk_fma_f32 v[116:117], v[118:119], v[76:77], v[116:117]
    v_pk_mul_f32 v[114:115], v[76:77], v[78:79]
    v_pk_mul_f32 v[104:105], v[104:105], v[106:107]
    v_pk_mul_f32 v[58:59], v[80:81], v[106:107]
    v_pk_mul_f32 v[112:113], v[112:113], v[114:115]
    v_pk_mul_f32 v[62:63], v[82:83], v[114:115]
    v_pk_fma_f32 v[56:57], v[108:109], v[80:81], v[104:105]
    v_pk_fma_f32 v[60:61], v[116:117], v[82:83], v[112:113]
    v_pk_mul_f32 v[64:65], v[88:89], s[70:71]
    v_pk_mul_f32 v[66:67], v[90:91], s[70:71]
    v_pk_mul_f32 v[68:69], v[92:93], s[70:71]
    v_pk_mul_f32 v[70:71], v[94:95], s[70:71]
    v_pk_mul_f32 v[72:73], v[96:97], s[70:71]
    v_pk_mul_f32 v[74:75], v[98:99], s[70:71]
    v_pk_mul_f32 v[76:77], v[100:101], s[70:71]
    v_pk_mul_f32 v[78:79], v[102:103], s[70:71]
    s_add_u32 s66, s66, 12
    s_cmp_lt_u32 s66, s37
    s_cbranch_scc1 K_LOOP
    v_rcp_f32 v58, v58
    v_rcp_f32 v59, v59
    v_rcp_f32 v62, v62
    v_rcp_f32 v63, v63
    s_nop 0
    v_mul_f32 v56, v56, v58
    v_mul_f32 v60, v60, v62
    v_fmac_f32 v56, v57, v59
    v_fmac_f32 v60, v61, v63
    v_cvt_f64_f32 v[84:85], v56
    v_cvt_f64_f32 v[86:87], v60
    ds_add_f64 v18, v[84:85] offset:256
    ds_add_f64 v19, v[86:87] offset:256
K_LOOPEND:
    s_waitcnt vmcnt(0)
    s_cmp_eq_u32 s36, 0
    s_cbranch_scc1 K_EPI
    s_add_u32 s15, s15, s39
    s_waitcnt lgkmcnt(0)
    s_barrier
    s_branch K_ROUND
K_EPI:
    s_mul_i32 s3, s13, 768
    s_add_u32 s3, s3, 38400
    v_lshl_add_u32 v3, v1, 3, s3
    v_add_u32 v2, 146944, v166
    s_lshl_b32 s3, s33, 11
    v_add_u32 v8, s3, v164
    v_xor_b32 v9, 64, v8
    v_xor_b32 v10, 64, v164
    s_waitcnt lgkmcnt(0)
    ds_read_b64_tr_b16 v[52:53], v2 offset:0
    ds_read_b64_tr_b16 v[54:55], v2 offset:512
    ds_read_b64_tr_b16 v[56:57], v2 offset:4096
    ds_read_b64_tr_b16 v[58:59], v2 offset:4608
    ds_read_b64_tr_b16 v[60:61], v2 offset:8192
    ds_read_b64_tr_b16 v[62:63], v2 offset:8704
    ds_read_b64_tr_b16 v[64:65], v2 offset:12288
    ds_read_b64_tr_b16 v[66:67], v2 offset:12800
    ds_read_b128 v[36:39], v8
    ds_read_b128 v[44:47], v164 offset:6144
    ds_read_b128 v[40:43], v9
    ds_read_b128 v[48:51], v10 offset:6144
    s_barrier
    ds_read_b64 v[96:97], v3 offset:0
    ds_read_b64 v[98:99], v3 offset:9216
    ds_read_b64 v[100:101], v3 offset:18432
    ds_read_b64 v[102:103], v3 offset:27648
    ds_read_b64 v[104:105], v3 offset:36864
    s_mul_i32 s3, s13, 144
    s_add_u32 s3, s3, 78336
    v_lshl_add_u32 v4, v1, 1, s3
    s_waitcnt lgkmcnt(4)
    v_cvt_f32_f64 v108, v[96:97]
    s_waitcnt lgkmcnt(3)
    v_cvt_f32_f64 v109, v[98:99]
    s_waitcnt lgkmcnt(2)
    v_cvt_f32_f64 v110, v[100:101]
    s_waitcnt lgkmcnt(1)
    v_cvt_f32_f64 v111, v[102:103]
    s_waitcnt lgkmcnt(0)
    v_cvt_f32_f64 v112, v[104:105]
    v_mul_f32 v108, s96, v108
    v_mul_f32 v109, s96, v109
    v_mul_f32 v110, s96, v110
    v_mul_f32 v111, s96, v111
    v_mul_f32 v112, s96, v112
    v_cvt_pk_bf16_f32 v108, v108, v108
    v_cvt_pk_bf16_f32 v109, v109, v109
    v_cvt_pk_bf16_f32 v110, v110, v110
    v_cvt_pk_bf16_f32 v111, v111, v111
    v_cvt_pk_bf16_f32 v112, v112, v112
    ds_write_b16 v4, v108 offset:0
    ds_write_b16 v4, v109 offset:1728
    ds_write_b16 v4, v110 offset:3456
    ds_write_b16 v4, v111 offset:5184
    ds_write_b16 v4, v112 offset:6912
    v_mul_u32_u24 v5, 144, v162
    v_lshl_add_u32 v5, v163, 4, v5
    v_add_u32 v5, 78336, v5
    s_mul_i32 s3, s33, 2304
    v_add_u32 v6, s3, v5
    s_waitcnt lgkmcnt(0)
    s_barrier
    ds_read_b128 v[68:71], v6
    ds_read_b128 v[76:79], v6 offset:64
    ds_read_b128 v[72:75], v5 offset:6912
    ds_read_b128 v[80:83], v5 offset:6976
    v_mfma_f32_16x16x32_bf16 v[88:91], v[52:55], v[36:39], 0
    v_mfma_f32_16x16x32_bf16 v[92:95], v[52:55], v[44:47], 0
    v_mfma_f32_16x16x32_bf16 v[88:91], v[56:59], v[40:43], v[88:91]
    v_mfma_f32_16x16x32_bf16 v[92:95], v[56:59], v[48:51], v[92:95]
    v_lshlrev_b32 v7, 7, v162
    v_cmp_eq_u32 s[40:41], 0, v162
    v_lshl_add_u32 v7, v163, 3, v7
    s_lshl_b32 s36, s34, 5
    s_add_u32 s68, s68, s36
    s_add_u32 s69, s69, s36
    s_mov_b32 s3, 0xffff0000
    s_waitcnt lgkmcnt(2)
    v_mfma_f32_16x16x32_bf16 v[88:91], v[60:63], v[68:71], v[88:91]
    v_mfma_f32_16x16x32_bf16 v[88:91], v[64:67], v[76:79], v[88:91]
    s_waitcnt lgkmcnt(0)
    v_mfma_f32_16x16x32_bf16 v[92:95], v[60:63], v[72:75], v[92:95]
    v_mfma_f32_16x16x32_bf16 v[92:95], v[64:67], v[80:83], v[92:95]
    s_nop 4
    v_cvt_pk_bf16_f32 v104, v88, v89
    v_cvt_pk_bf16_f32 v105, v90, v91
    v_lshlrev_b32 v88, 16, v104
    v_and_b32 v89, s3, v104
    v_lshlrev_b32 v90, 16, v105
    v_and_b32 v91, s3, v105
    v_mul_f32 v96, s70, v88
    v_mul_f32 v97, s70, v89
    v_mul_f32 v98, s70, v90
    v_mul_f32 v99, s70, v91
    v_exp_f32 v96, v96
    v_exp_f32 v97, v97
    v_exp_f32 v98, v98
    v_exp_f32 v99, v99
    v_add_f32 v96, 1.0, v96
    v_add_f32 v97, 1.0, v97
    v_add_f32 v98, 1.0, v98
    v_add_f32 v99, 1.0, v99
    v_rcp_f32 v96, v96
    v_rcp_f32 v97, v97
    v_rcp_f32 v98, v98
    v_rcp_f32 v99, v99
    v_mul_f32 v96, v88, v96
    v_mul_f32 v97, v89, v97
    v_mul_f32 v98, v90, v98
    v_mul_f32 v99, v91, v99
    v_cvt_pk_bf16_f32 v106, v96, v97
    v_cvt_pk_bf16_f32 v107, v98, v99
    buffer_store_dwordx2 v[106:107], v7, s[28:31], s68 offen
    s_cmp_ge_u32 s13, 4
    s_cbranch_scc1 K_NOST
    v_cvt_pk_bf16_f32 v104, v92, v93
    v_cvt_pk_bf16_f32 v105, v94, v95
    v_lshlrev_b32 v92, 16, v104
    v_and_b32 v93, s3, v104
    v_lshlrev_b32 v94, 16, v105
    v_and_b32 v95, s3, v105
    v_mul_f32 v96, s70, v92
    v_mul_f32 v97, s70, v93
    v_mul_f32 v98, s70, v94
    v_mul_f32 v99, s70, v95
    v_exp_f32 v96, v96
    v_exp_f32 v97, v97
    v_exp_f32 v98, v98
    v_exp_f32 v99, v99
    v_add_f32 v96, 1.0, v96
    v_add_f32 v97, 1.0, v97
    v_add_f32 v98, 1.0, v98
    v_add_f32 v99, 1.0, v99
    v_rcp_f32 v96, v96
    v_rcp_f32 v97, v97
    v_rcp_f32 v98, v98
    v_rcp_f32 v99, v99
    v_mul_f32 v96, v92, v96
    v_mul_f32 v97, v93, v97
    v_mul_f32 v98, v94, v98
    v_mul_f32 v99, v95, v99
    v_cvt_pk_bf16_f32 v106, v96, v97
    v_cvt_pk_bf16_f32 v107, v98, v99
    s_mov_b64 exec, s[40:41]
    buffer_store_dwordx2 v[106:107], v7, s[28:31], s69 offen
    s_mov_b64 exec, -1
K_NOST:
K_END:
    s_endpgm
K_CODE_END:
.section .rodata,"a"
.p2align 6
.amdhsa_kernel standalone__mpnn_edge_mlp__graph_kernel
  .amdhsa_next_free_vgpr 168
  .amdhsa_next_free_sgpr 102
  .amdhsa_accum_offset 168
  .amdhsa_group_segment_fixed_size 0
  .amdhsa_kernarg_size 72
  .amdhsa_user_sgpr_count 2
  .amdhsa_user_sgpr_kernarg_segment_ptr 1
  .amdhsa_system_sgpr_workgroup_id_x 1
  .amdhsa_float_denorm_mode_32 3
.end_amdhsa_kernel
```
